```python
import torch

def _softmax(x, axis=-1):
    return torch.softmax(x, dim=axis)
def _gelu(x):
    return torch.nn.functional.gelu(x, approximate="tanh")
def _silu(x):
    return torch.nn.functional.silu(x)
def _sigmoid(x):
    return torch.sigmoid(x)
def _layernorm(x, axis=-1, eps=1e-5):
    m = x.mean(dim=axis, keepdim=True)
    v = x.var(dim=axis, keepdim=True, unbiased=False)
    return (x - m) / torch.sqrt(v + eps)
def _scatter_add(tgt, idx, src, axis=0):
    return tgt.clone().index_add_(axis, idx, src)
def _segment_sum(src, seg, n):
    out = torch.zeros((n,) + src.shape[1:], dtype=src.dtype)
    return out.index_add_(0, seg, src)
def _pad(x, pw):
    flat = tuple(v for pair in reversed(pw) for v in pair)
    return torch.nn.functional.pad(x, flat)

kernel_name = 'standalone__deepnorm__sampling'

def setup_inputs():

    _w = (lambda a: (lambda t: t.to(torch.bfloat16) if t.is_floating_point() else t)(torch.as_tensor(a)))
    B, S, D = 1024, 16, 512
    return {
        "x": _w((lambda *s: torch.randn(*s, dtype=torch.bfloat16) * 0.05)(B, S, D)),
        "f": _w((lambda *s: torch.randn(*s, dtype=torch.bfloat16) * 0.05)(B, S, D)),
        "g": _w((lambda *s: torch.randn(*s, dtype=torch.bfloat16) * 0.05)(D) + 1.0),
        "b": _w((lambda *s: torch.randn(*s, dtype=torch.bfloat16) * 0.4)(D)),
        "alpha": _w(float(2.0)),
    }

def reference(x, f, g, b, alpha):
    return _layernorm(alpha * x + f, axis=-1) * g + b
```

```asm
; @launch grid=(512,1,1) block=(256,1,1) lds=0
.amdgcn_target "amdgcn-amd-amdhsa--gfx950"
.text

.set vOFF, 0
.set vLANE, 1
.set vS0, 2
.set vS1, 10
.set vS2, 18
.set vG, 26
.set vB, 34
.set vT, 42
.set vP, 50
.set vC, 54
.set vR, 58

.macro LOADROW slot, soff
    buffer_load_dwordx4 v[\slot:\slot+3], v[vOFF], s[4:7], \soff offen nt
    buffer_load_dwordx4 v[\slot+4:\slot+7], v[vOFF], s[8:11], \soff offen nt
.endm

.macro PAD2 first, dst, src
.if \first
    v_lshlrev_b32 v[\dst], 16, v[\src]
    v_and_b32 v[\dst+1], 0xffff0000, v[\src]
.else
    s_nop 1
.endif
.endm

.macro ROW x, first
    v_lshlrev_b32 v[vT], 16, v[\x+4]
    v_and_b32 v[vT+1], 0xffff0000, v[\x+4]
    v_lshlrev_b32 v[vT+2], 16, v[\x+5]
    v_and_b32 v[vT+3], 0xffff0000, v[\x+5]
    v_lshlrev_b32 v[vT+4], 16, v[\x+6]
    v_and_b32 v[vT+5], 0xffff0000, v[\x+6]
    v_lshlrev_b32 v[vT+6], 16, v[\x+7]
    v_and_b32 v[vT+7], 0xffff0000, v[\x+7]
    v_dot2c_f32_bf16 v[vT], s20, v[\x]
    v_dot2c_f32_bf16 v[vT+1], s21, v[\x]
    v_dot2c_f32_bf16 v[vT+2], s20, v[\x+1]
    v_dot2c_f32_bf16 v[vT+3], s21, v[\x+1]
    v_dot2c_f32_bf16 v[vT+4], s20, v[\x+2]
    v_dot2c_f32_bf16 v[vT+5], s21, v[\x+2]
    v_dot2c_f32_bf16 v[vT+6], s20, v[\x+3]
    v_dot2c_f32_bf16 v[vT+7], s21, v[\x+3]
    v_cvt_pk_bf16_f32 v[vP], v[vT], v[vT+1]
    v_cvt_pk_bf16_f32 v[vP+1], v[vT+2], v[vT+3]
    v_readfirstlane_b32 s24, v[vP]
    v_cvt_pk_bf16_f32 v[vP+2], v[vT+4], v[vT+5]
    v_cvt_pk_bf16_f32 v[vP+3], v[vT+6], v[vT+7]
    s_lshl_b32 s24, s24, 16
    v_dot2_f32_bf16 v[\x], v[vP], v[vC], s24
    v_dot2_f32_bf16 v[\x+1], v[vP], v[vC+1], s24
    v_dot2_f32_bf16 v[\x+2], v[vP+1], v[vC], s24
    v_dot2_f32_bf16 v[\x+3], v[vP+1], v[vC+1], s24
    v_dot2_f32_bf16 v[\x+4], v[vP+2], v[vC], s24
    v_dot2_f32_bf16 v[\x+5], v[vP+2], v[vC+1], s24
    v_dot2_f32_bf16 v[\x+6], v[vP+3], v[vC], s24
    v_dot2_f32_bf16 v[\x+7], v[vP+3], v[vC+1], s24
    v_pk_mul_f32 v[vT:vT+1], v[\x:\x+1], v[\x:\x+1]
    v_pk_add_f32 v[vT+2:vT+3], v[\x:\x+1], v[\x+2:\x+3]
    v_pk_fma_f32 v[vT:vT+1], v[\x+2:\x+3], v[\x+2:\x+3], v[vT:vT+1]
    v_pk_add_f32 v[vT+2:vT+3], v[vT+2:vT+3], v[\x+4:\x+5]
    v_pk_fma_f32 v[vT:vT+1], v[\x+4:\x+5], v[\x+4:\x+5], v[vT:vT+1]
    v_pk_add_f32 v[vT+2:vT+3], v[vT+2:vT+3], v[\x+6:\x+7]
    v_pk_fma_f32 v[vT:vT+1], v[\x+6:\x+7], v[\x+6:\x+7], v[vT:vT+1]
    v_add_f32 v[vR], v[vT+2], v[vT+3]
    v_add_f32 v[vR+1], v[vT], v[vT+1]
.if \first
    s_waitcnt vmcnt(4)
.endif
    PAD2 \first, vG, vG+4
    v_permlane32_swap_b32 v[vR], v[vR+1]
    v_add_f32 v[vR], v[vR], v[vR+1]
    PAD2 \first, vG+2, vG+5
    v_add_f32_dpp v[vR], v[vR], v[vR] quad_perm:[1,0,3,2] row_mask:0xf bank_mask:0xf
    PAD2 \first, vG+4, vG+6
    v_add_f32_dpp v[vR], v[vR], v[vR] quad_perm:[2,3,0,1] row_mask:0xf bank_mask:0xf
    PAD2 \first, vG+6, vG+7
    v_add_f32_dpp v[vR], v[vR], v[vR] row_half_mirror row_mask:0xf bank_mask:0xf
    PAD2 \first, vB, vB+4
    v_add_f32_dpp v[vR], v[vR], v[vR] row_mirror row_mask:0xf bank_mask:0xf
    PAD2 \first, vB+2, vB+5
    v_add_f32_dpp v[vR], v[vR], v[vR] row_bcast:15 row_mask:0xa bank_mask:0xf
    s_nop 0
    v_readlane_b32 s25, v[vR], 31
    v_readlane_b32 s26, v[vR], 63
    s_nop 0
    v_mul_f32 v[vR], s25, v[vC+2]
    v_mul_f32 v[vR+1], s26, v[vC+2]
    v_fma_f32 v[vR+1], -v[vR], v[vR], v[vR+1]
    v_cvt_pk_bf16_f32 v[vR+1], 0, v[vR+1]
    v_add_f32 v[vR+1], s23, v[vR+1]
    v_cvt_pk_bf16_f32 v[vR+1], 0, v[vR+1]
    v_sqrt_f32 v[vR+1], v[vR+1]
    v_sub_f32 v[vR], s24, v[vR]
    v_cvt_pk_bf16_f32 v[vR+1], 0, v[vR+1]
    v_cvt_pk_bf16_f32 v[vR], 0, v[vR]
    v_rcp_f32 v[vR+2], v[vR+1]
    v_sub_f32 v[vR], s24, v[vR]
    v_mul_f32 v[vR+3], v[vR], v[vR+2]
.if \first
    PAD2 1, vB+4, vB+6
    PAD2 1, vB+6, vB+7
.endif
    v_pk_fma_f32 v[\x:\x+1], v[\x:\x+1], v[vR+2:vR+3], v[vR+2:vR+3] op_sel:[0,0,1] op_sel_hi:[1,0,1] neg_lo:[0,1,0] neg_hi:[0,1,0]
    v_pk_fma_f32 v[\x+2:\x+3], v[\x+2:\x+3], v[vR+2:vR+3], v[vR+2:vR+3] op_sel:[0,0,1] op_sel_hi:[1,0,1] neg_lo:[0,1,0] neg_hi:[0,1,0]
    v_pk_fma_f32 v[\x+4:\x+5], v[\x+4:\x+5], v[vR+2:vR+3], v[vR+2:vR+3] op_sel:[0,0,1] op_sel_hi:[1,0,1] neg_lo:[0,1,0] neg_hi:[0,1,0]
    v_pk_fma_f32 v[\x+6:\x+7], v[\x+6:\x+7], v[vR+2:vR+3], v[vR+2:vR+3] op_sel:[0,0,1] op_sel_hi:[1,0,1] neg_lo:[0,1,0] neg_hi:[0,1,0]
    v_pk_fma_f32 v[\x:\x+1], v[\x:\x+1], v[vG:vG+1], v[vB:vB+1]
    v_pk_fma_f32 v[\x+2:\x+3], v[\x+2:\x+3], v[vG+2:vG+3], v[vB+2:vB+3]
    v_pk_fma_f32 v[\x+4:\x+5], v[\x+4:\x+5], v[vG+4:vG+5], v[vB+4:vB+5]
    v_pk_fma_f32 v[\x+6:\x+7], v[\x+6:\x+7], v[vG+6:vG+7], v[vB+6:vB+7]
    v_cvt_pk_bf16_f32 v[vP], v[\x], v[\x+1]
    v_cvt_pk_bf16_f32 v[vP+1], v[\x+2], v[\x+3]
    v_cvt_pk_bf16_f32 v[vP+2], v[\x+4], v[\x+5]
    v_cvt_pk_bf16_f32 v[vP+3], v[\x+6], v[\x+7]
.endm

.globl standalone__deepnorm__sampling_kernel
.p2align 8
.type standalone__deepnorm__sampling_kernel,@function
standalone__deepnorm__sampling_kernel:
    s_load_dwordx2 s[4:5], s[0:1], 0
    s_load_dwordx2 s[8:9], s[0:1], 8
    s_load_dwordx4 s[16:19], s[0:1], 16
    s_load_dwordx2 s[28:29], s[0:1], 32
    s_load_dwordx2 s[12:13], s[0:1], 40
    s_cmp_ge_u32 s2, 512
    s_cbranch_scc1 L_end
    s_and_b32 s27, s2, 7
    s_lshl_b32 s27, s27, 2
    s_bfe_u32 s3, s2, 0x20003
    s_or_b32 s27, s27, s3
    s_andn2_b32 s3, s2, 31
    s_or_b32 s27, s27, s3
    s_lshl_b32 s3, s27, 12
    v_lshlrev_b32 v[vLANE], 4, v0
    v_add_u32 v[vOFF], s3, v[vLANE]
    v_and_b32 v[vLANE], 0x3ff, v[vLANE]
    s_mov_b32 s6, 0x1000000
    s_mov_b32 s7, 0x20000
    s_mov_b32 s10, 0x1000000
    s_mov_b32 s11, 0x20000
    s_mov_b32 s14, 0x1000000
    s_mov_b32 s15, 0x20000
    s_mov_b32 s31, 0x200000
    s_mov_b32 s32, 0x400000
    s_mov_b32 s33, 0x600000
    s_mov_b32 s34, 0x800000
    s_mov_b32 s35, 0xa00000
    s_mov_b32 s36, 0xc00000
    s_mov_b32 s37, 0xe00000
    s_waitcnt lgkmcnt(0)
    LOADROW vS0, 0
    global_load_dwordx4 v[vG+4:vG+7], v[vLANE], s[16:17]
    global_load_dwordx4 v[vB+4:vB+7], v[vLANE], s[18:19]
    LOADROW vS1, s31
    s_load_dword s20, s[28:29], 0
    s_mov_b32 s23, 0x3727c5ac
    v_mov_b32 v[vC], 0xbf80
    v_mov_b32 v[vC+1], 0xbf800000
    v_mov_b32 v[vC+2], 0x3b000000
    s_waitcnt vmcnt(4)
    LOADROW vS2, s32
    s_waitcnt lgkmcnt(0)
    s_lshl_b32 s21, s20, 16
    s_and_b32 s20, s20, 0xffff
    ROW vS0, 1
    buffer_store_dwordx4 v[vP:vP+3], v[vOFF], s[12:15], 0 offen
    s_waitcnt vmcnt(3)
    LOADROW vS0, s33
    ROW vS1, 0
    buffer_store_dwordx4 v[vP:vP+3], v[vOFF], s[12:15], s31 offen
    s_waitcnt vmcnt(4)
    LOADROW vS1, s34
    ROW vS2, 0
    buffer_store_dwordx4 v[vP:vP+3], v[vOFF], s[12:15], s32 offen sc1
    s_waitcnt vmcnt(4)
    LOADROW vS2, s35
    ROW vS0, 0
    buffer_store_dwordx4 v[vP:vP+3], v[vOFF], s[12:15], s33 offen sc1
    s_waitcnt vmcnt(4)
    LOADROW vS0, s36
    ROW vS1, 0
    buffer_store_dwordx4 v[vP:vP+3], v[vOFF], s[12:15], s34 offen sc1
    s_waitcnt vmcnt(4)
    LOADROW vS1, s37
    ROW vS2, 0
    buffer_store_dwordx4 v[vP:vP+3], v[vOFF], s[12:15], s35 offen sc1
    s_waitcnt vmcnt(4)
    ROW vS0, 0
    buffer_store_dwordx4 v[vP:vP+3], v[vOFF], s[12:15], s36 offen
    s_waitcnt vmcnt(2)
    ROW vS1, 0
    buffer_store_dwordx4 v[vP:vP+3], v[vOFF], s[12:15], s37 offen
L_end:
    s_endpgm
.section .rodata,"a"
.p2align 6
.amdhsa_kernel standalone__deepnorm__sampling_kernel
  .amdhsa_next_free_vgpr 62
  .amdhsa_next_free_sgpr 40
  .amdhsa_accum_offset 64
  .amdhsa_group_segment_fixed_size 0
  .amdhsa_kernarg_size 64
  .amdhsa_user_sgpr_count 2
  .amdhsa_user_sgpr_kernarg_segment_ptr 1
  .amdhsa_system_sgpr_workgroup_id_x 1
  .amdhsa_float_denorm_mode_32 3
.end_amdhsa_kernel
```

```asm
; @launch grid=(512,1,1) block=(256,1,1) lds=0
.amdgcn_target "amdgcn-amd-amdhsa--gfx950"
.text

.set vOFF, 0
.set vLANE, 1
.set vS0, 2
.set vS1, 10
.set vS2, 18
.set vG, 26
.set vB, 34
.set vT, 42
.set vP, 50
.set vC, 54
.set vR, 58
.set vEVEN, 62
.set vODD, 63
.set vZERO, 64

.macro LOADROW slot, voff, soff
    buffer_load_dwordx4 v[\slot:\slot+3], v[\voff], s[4:7], \soff offen nt
    buffer_load_dwordx4 v[\slot+4:\slot+7], v[\voff], s[8:11], \soff offen nt
.endm

.macro STOREROW voff, soff
    buffer_store_dwordx4 v[vP:vP+3], v[\voff], s[12:15], \soff offen sc1
.endm

.macro PAD2 first, dst, src
.if \first
    v_lshlrev_b32 v[\dst], 16, v[\src]
    v_and_b32 v[\dst+1], 0xffff0000, v[\src]
.else
    s_nop 1
.endif
.endm

.macro ROW x, first
    v_lshlrev_b32 v[vT], 16, v[\x+4]
    v_and_b32 v[vT+1], 0xffff0000, v[\x+4]
    v_lshlrev_b32 v[vT+2], 16, v[\x+5]
    v_and_b32 v[vT+3], 0xffff0000, v[\x+5]
    v_lshlrev_b32 v[vT+4], 16, v[\x+6]
    v_and_b32 v[vT+5], 0xffff0000, v[\x+6]
    v_lshlrev_b32 v[vT+6], 16, v[\x+7]
    v_and_b32 v[vT+7], 0xffff0000, v[\x+7]
    v_dot2c_f32_bf16 v[vT], s20, v[\x]
    v_dot2c_f32_bf16 v[vT+1], s21, v[\x]
    v_dot2c_f32_bf16 v[vT+2], s20, v[\x+1]
    v_dot2c_f32_bf16 v[vT+3], s21, v[\x+1]
    v_dot2c_f32_bf16 v[vT+4], s20, v[\x+2]
    v_dot2c_f32_bf16 v[vT+5], s21, v[\x+2]
    v_dot2c_f32_bf16 v[vT+6], s20, v[\x+3]
    v_dot2c_f32_bf16 v[vT+7], s21, v[\x+3]
    v_cvt_pk_bf16_f32 v[vP], v[vT], v[vT+1]
    v_cvt_pk_bf16_f32 v[vP+1], v[vT+2], v[vT+3]
    v_readfirstlane_b32 s24, v[vP]
    v_cvt_pk_bf16_f32 v[vP+2], v[vT+4], v[vT+5]
    v_cvt_pk_bf16_f32 v[vP+3], v[vT+6], v[vT+7]
    s_lshl_b32 s24, s24, 16
    v_dot2_f32_bf16 v[\x], v[vP], v[vC], s24
    v_dot2_f32_bf16 v[\x+1], v[vP], v[vC+1], s24
    v_dot2_f32_bf16 v[\x+2], v[vP+1], v[vC], s24
    v_dot2_f32_bf16 v[\x+3], v[vP+1], v[vC+1], s24
    v_dot2_f32_bf16 v[\x+4], v[vP+2], v[vC], s24
    v_dot2_f32_bf16 v[\x+5], v[vP+2], v[vC+1], s24
    v_dot2_f32_bf16 v[\x+6], v[vP+3], v[vC], s24
    v_dot2_f32_bf16 v[\x+7], v[vP+3], v[vC+1], s24
    v_pk_mul_f32 v[vT:vT+1], v[\x:\x+1], v[\x:\x+1]
    v_pk_add_f32 v[vT+2:vT+3], v[\x:\x+1], v[\x+2:\x+3]
    v_pk_fma_f32 v[vT:vT+1], v[\x+2:\x+3], v[\x+2:\x+3], v[vT:vT+1]
    v_pk_add_f32 v[vT+2:vT+3], v[vT+2:vT+3], v[\x+4:\x+5]
    v_pk_fma_f32 v[vT:vT+1], v[\x+4:\x+5], v[\x+4:\x+5], v[vT:vT+1]
    v_pk_add_f32 v[vT+2:vT+3], v[vT+2:vT+3], v[\x+6:\x+7]
    v_pk_fma_f32 v[vT:vT+1], v[\x+6:\x+7], v[\x+6:\x+7], v[vT:vT+1]
    v_add_f32 v[vR], v[vT+2], v[vT+3]
    v_add_f32 v[vR+1], v[vT], v[vT+1]
    PAD2 \first, vG, vG+4
    v_permlane32_swap_b32 v[vR], v[vR+1]
    v_add_f32 v[vR], v[vR], v[vR+1]
    PAD2 \first, vG+2, vG+5
    v_add_f32_dpp v[vR], v[vR], v[vR] quad_perm:[1,0,3,2] row_mask:0xf bank_mask:0xf
    PAD2 \first, vG+4, vG+6
    v_add_f32_dpp v[vR], v[vR], v[vR] quad_perm:[2,3,0,1] row_mask:0xf bank_mask:0xf
    PAD2 \first, vG+6, vG+7
    v_add_f32_dpp v[vR], v[vR], v[vR] row_half_mirror row_mask:0xf bank_mask:0xf
    PAD2 \first, vB, vB+4
    v_add_f32_dpp v[vR], v[vR], v[vR] row_mirror row_mask:0xf bank_mask:0xf
    PAD2 \first, vB+2, vB+5
    v_add_f32_dpp v[vR], v[vR], v[vR] row_bcast:15 row_mask:0xa bank_mask:0xf
    s_nop 0
    v_readlane_b32 s25, v[vR], 31
    v_readlane_b32 s26, v[vR], 63
    s_nop 0
    v_mul_f32 v[vR], s25, v[vC+2]
    v_mul_f32 v[vR+1], s26, v[vC+2]
    v_fma_f32 v[vR+1], -v[vR], v[vR], v[vR+1]
    v_cvt_pk_bf16_f32 v[vR+1], 0, v[vR+1]
    v_add_f32 v[vR+1], s23, v[vR+1]
    v_cvt_pk_bf16_f32 v[vR+1], 0, v[vR+1]
    v_sqrt_f32 v[vR+1], v[vR+1]
    v_sub_f32 v[vR], s24, v[vR]
    v_cvt_pk_bf16_f32 v[vR+1], 0, v[vR+1]
    v_cvt_pk_bf16_f32 v[vR], 0, v[vR]
    v_rcp_f32 v[vR+2], v[vR+1]
    v_sub_f32 v[vR], s24, v[vR]
    v_mul_f32 v[vR+3], v[vR], v[vR+2]
.if \first
    PAD2 1, vB+4, vB+6
    PAD2 1, vB+6, vB+7
.endif
    v_pk_fma_f32 v[\x:\x+1], v[\x:\x+1], v[vR+2:vR+3], v[vR+2:vR+3] op_sel:[0,0,1] op_sel_hi:[1,0,1] neg_lo:[0,1,0] neg_hi:[0,1,0]
    v_pk_fma_f32 v[\x+2:\x+3], v[\x+2:\x+3], v[vR+2:vR+3], v[vR+2:vR+3] op_sel:[0,0,1] op_sel_hi:[1,0,1] neg_lo:[0,1,0] neg_hi:[0,1,0]
    v_pk_fma_f32 v[\x+4:\x+5], v[\x+4:\x+5], v[vR+2:vR+3], v[vR+2:vR+3] op_sel:[0,0,1] op_sel_hi:[1,0,1] neg_lo:[0,1,0] neg_hi:[0,1,0]
    v_pk_fma_f32 v[\x+6:\x+7], v[\x+6:\x+7], v[vR+2:vR+3], v[vR+2:vR+3] op_sel:[0,0,1] op_sel_hi:[1,0,1] neg_lo:[0,1,0] neg_hi:[0,1,0]
    v_pk_fma_f32 v[\x:\x+1], v[\x:\x+1], v[vG:vG+1], v[vB:vB+1]
    v_pk_fma_f32 v[\x+2:\x+3], v[\x+2:\x+3], v[vG+2:vG+3], v[vB+2:vB+3]
    v_pk_fma_f32 v[\x+4:\x+5], v[\x+4:\x+5], v[vG+4:vG+5], v[vB+4:vB+5]
    v_pk_fma_f32 v[\x+6:\x+7], v[\x+6:\x+7], v[vG+6:vG+7], v[vB+6:vB+7]
    v_cvt_pk_bf16_f32 v[vP], v[\x], v[\x+1]
    v_cvt_pk_bf16_f32 v[vP+1], v[\x+2], v[\x+3]
    v_cvt_pk_bf16_f32 v[vP+2], v[\x+4], v[\x+5]
    v_cvt_pk_bf16_f32 v[vP+3], v[\x+6], v[\x+7]
.endm

.macro MAPSTEPS
    s_lshr_b32 s36, s34, 4
    s_add_u32 s36, s36, s2
    s_bfe_u32 s22, s36, 0x10001
    s_lshl_b32 s22, s22, 7
    s_bfe_u32 s3, s36, 0x10000
    s_lshl_b32 s3, s3, 8
    s_or_b32 s22, s22, s3
    s_bfe_u32 s3, s36, 0x10002
    s_lshl_b32 s3, s3, 1
    s_or_b32 s22, s22, s3
    s_or_b32 s22, s22, s37
    s_lshr_b32 s3, s34, 8
    s_xor_b32 s3, s3, s34
    s_and_b32 s3, s3, 2
    s_or_b32 s3, s3, s38
    s_cselect_b32 s3, 16, 0
    s_cselect_b32 s36, s12, s4
    s_lshr_b32 s34, s34, s3
    s_and_b32 s34, s34, 2
    s_xor_b32 s22, s22, s34
    s_xor_b32 s3, s22, 2
    s_lshr_b32 s36, s36, 12
    s_sub_u32 s22, s22, s36
    s_sub_u32 s3, s3, s36
    s_and_b32 s22, s22, 0x1ff
    s_and_b32 s3, s3, 0x1ff
    s_lshl_b32 s22, s22, 12
    s_lshl_b32 s3, s3, 12
    v_add_u32 v[vODD], s3, v[vEVEN]
    v_add_u32 v[vEVEN], s22, v[vEVEN]
    LOADROW vS0, vODD, s43
.endm

.globl standalone__deepnorm__sampling_kernel
.p2align 8
.type standalone__deepnorm__sampling_kernel,@function
standalone__deepnorm__sampling_kernel:
    s_load_dwordx2 s[4:5], s[0:1], 0
    s_load_dwordx2 s[8:9], s[0:1], 8
    v_readfirstlane_b32 s34, v0
    s_sub_u32 s35, s2, 1
    s_load_dwordx2 s[12:13], s[0:1], 40
    s_load_dwordx2 s[32:33], s[0:1], 48
    s_load_dwordx4 s[16:19], s[0:1], 16
    s_load_dwordx2 s[28:29], s[0:1], 32
    s_and_b32 s36, s35, 0xff27
    s_or_b32 s36, s36, s34
    s_cbranch_scc1 L_main
    s_bfe_u32 s34, s35, 0x20003
    s_lshr_b32 s35, s35, 6
    s_lshl2_add_u32 s34, s35, s34
    s_cmpk_ge_u32 s34, 9
    s_mov_b32 s36, 1
    s_cbranch_scc1 L_main
    s_mul_i32 s35, s34, 86
    s_lshr_b32 s35, s35, 8
    s_mul_i32 s3, s35, 3
    s_sub_u32 s26, s34, s3
    s_mul_i32 s25, s35, 0x14900
    s_add_u32 s25, s25, 0x800000
    s_getreg_b32 s21, hwreg(HW_REG_XCC_ID, 0, 3)
    s_sub_u32 s20, s21, s2
    s_and_b32 s20, s20, 7
    s_lshl_b32 s20, s20, 4
    s_cmp_eq_u32 s34, 0
    s_cselect_b32 s20, s20, 0
    s_cmp_eq_u32 s26, 0
    s_waitcnt lgkmcnt(0)
    s_cselect_b64 s[36:37], s[4:5], s[8:9]
    s_cmp_eq_u32 s26, 2
    s_cselect_b64 s[36:37], s[12:13], s[36:37]
    s_add_u32 s36, s36, s25
    s_addc_u32 s37, s37, 0
    s_bitset0_b32 s36, 13
    s_load_dword s48, s[36:37], 0
    s_load_dword s49, s[36:37], 0x2000
    s_waitcnt lgkmcnt(1)
    s_lshr_b32 s21, s21, 2
    s_bitset1_b32 s20, 24
    s_lshl_b32 s34, s26, 3
    s_getreg_b32 s50, hwreg(HW_REG_IB_STS, 8, 4)
    s_cmp_eq_u32 s50, 0
    s_cselect_b32 s50, 1, 0
    s_xor_b32 s50, s50, s21
    s_lshl_b32 s50, s50, s34
    s_or_b32 s50, s50, s20
    s_atomic_add s50, s[32:33], 60
    s_atomic_add s50, s[32:33], 124
    s_atomic_add s50, s[32:33], 188
    s_mov_b32 s36, 0
L_main:
    s_cmpk_ge_u32 s2, 512
    s_cbranch_scc1 L_end
    s_and_b32 s27, s2, 7
    s_lshl_b32 s27, s27, 2
    s_bfe_u32 s3, s2, 0x20003
    s_or_b32 s27, s27, s3
    s_andn2_b32 s3, s2, 31
    s_or_b32 s27, s27, s3
    s_lshl_b32 s27, s27, 12
    v_lshlrev_b32 v[vEVEN], 4, v0
    v_add_u32 v[vOFF], s27, v[vEVEN]
    v_and_b32 v[vLANE], 0x3ff, v[vEVEN]
    s_mov_b32 s6, 0x1000000
    s_mov_b32 s7, 0x20000
    s_mov_b32 s10, 0x1000000
    s_mov_b32 s11, 0x20000
    s_mov_b32 s41, 0x200000
    v_mov_b32 v[vZERO], 0
    s_cmp_eq_u32 s36, 0
    s_cbranch_scc1 L_go
    s_waitcnt lgkmcnt(0)
L_go:
    LOADROW vS0, vOFF, 0
    global_load_dwordx4 v[vG+4:vG+7], v[vLANE], s[16:17]
    global_load_dwordx4 v[vB+4:vB+7], v[vLANE], s[18:19]
    global_load_ushort v[vC+3], v[vZERO], s[28:29]
    LOADROW vS1, vOFF, s41
    s_mov_b32 s14, 0x1000000
    s_mov_b32 s15, 0x20000
    s_mov_b32 s42, 0x400000
    s_mov_b32 s43, 0x600000
    s_mov_b32 s44, 0x800000
    s_mov_b32 s45, 0xa00000
    s_mov_b32 s46, 0xc00000
    s_mov_b32 s47, 0xe00000
    s_mov_b32 s23, 0x3727c5ac
    v_mov_b32 v[vC], 0xbf80
    v_mov_b32 v[vC+1], 0xbf800000
    v_mov_b32 v[vC+2], 0x3b000000
    v_mov_b32 v[vODD], v[vOFF]
    s_bfe_u32 s37, s2, 0x10004
    s_bfe_u32 s3, s2, 0x10003
    s_lshl_b32 s3, s3, 2
    s_or_b32 s37, s37, s3
    s_bfe_u32 s3, s2, 0x40005
    s_lshl_b32 s3, s3, 3
    s_or_b32 s37, s37, s3
    s_xor_b32 s38, s4, s8
    s_and_b32 s38, s38, 0x3fff
    s_waitcnt vmcnt(5)
    LOADROW vS2, vOFF, s42
    s_waitcnt vmcnt(4)
    v_readfirstlane_b32 s20, v[vC+3]
    s_lshl_b32 s21, s20, 16
    ROW vS0, 1
    STOREROW vOFF, 0
    s_load_dword s34, s[32:33], 60
    s_waitcnt vmcnt(3)
    s_mov_b32 s35, 0
    s_waitcnt lgkmcnt(0)
    s_cmp_ge_u32 s34, 0x9000000
    s_cbranch_scc0 L_later
    MAPSTEPS
    s_mov_b32 s35, 1
L_later:
    s_load_dword s34, s[32:33], 124
    ROW vS1, 0
    STOREROW vOFF, s41
    s_cmp_eq_u32 s35, 0
    s_cbranch_scc1 L_retry
L_mapped:
    s_waitcnt vmcnt(4)
    LOADROW vS1, vEVEN, s44
    ROW vS2, 0
    STOREROW vOFF, s42
    s_waitcnt vmcnt(3)
    LOADROW vS2, vODD, s45
    ROW vS0, 0
    STOREROW vODD, s43
    s_waitcnt vmcnt(4)
    LOADROW vS0, vEVEN, s46
    ROW vS1, 0
    STOREROW vEVEN, s44
    s_waitcnt vmcnt(4)
    LOADROW vS1, vODD, s47
    ROW vS2, 0
    STOREROW vODD, s45
    s_waitcnt vmcnt(4)
    ROW vS0, 0
    STOREROW vEVEN, s46
    s_waitcnt vmcnt(2)
    ROW vS1, 0
    STOREROW vODD, s47
L_end:
    s_endpgm

L_retry:
    s_waitcnt lgkmcnt(0)
    s_cmp_ge_u32 s34, 0x9000000
    s_cbranch_scc1 L_have
    s_load_dword s34, s[32:33], 188
    s_movk_i32 s36, 0x7fff
    s_waitcnt lgkmcnt(0)
L_poll:
    s_cmp_ge_u32 s34, 0x9000000
    s_cbranch_scc1 L_have
    s_sub_u32 s36, s36, 1
    s_cbranch_scc1 L_have
    global_load_dword v[vODD], v[vZERO], s[32:33] offset:60 sc1
    s_waitcnt vmcnt(0)
    v_readfirstlane_b32 s34, v[vODD]
    s_branch L_poll
L_have:
    MAPSTEPS
    s_branch L_mapped

.section .rodata,"a"
.p2align 6
.amdhsa_kernel standalone__deepnorm__sampling_kernel
  .amdhsa_next_free_vgpr 65
  .amdhsa_next_free_sgpr 52
  .amdhsa_accum_offset 68
  .amdhsa_group_segment_fixed_size 0
  .amdhsa_kernarg_size 64
  .amdhsa_user_sgpr_count 2
  .amdhsa_user_sgpr_kernarg_segment_ptr 1
  .amdhsa_system_sgpr_workgroup_id_x 1
  .amdhsa_float_denorm_mode_32 3
.end_amdhsa_kernel
```

```asm
; @launch grid=(512,1,1) block=(256,1,1) lds=0
.amdgcn_target "amdgcn-amd-amdhsa--gfx950"
.text

.set vOFF, 0
.set vLANE, 1
.set vS0, 2
.set vS1, 10
.set vS2, 18
.set vG, 26
.set vB, 34
.set vT, 42
.set vP, 50
.set vC, 54
.set vR, 58
.set vEVEN, 62
.set vODD, 63
.set vZERO, 64
.set vH0, 66
.set vH1, 70
.set vH2, 74

.macro LOADROW slot, voff, soff
    buffer_load_dwordx4 v[\slot:\slot+3], v[\voff], s[4:7], \soff offen nt
    buffer_load_dwordx4 v[\slot+4:\slot+7], v[\voff], s[8:11], \soff offen nt
.endm

.macro STOREROW row, voff, soff
    buffer_store_dwordx4 v[\row:\row+3], v[\voff], s[12:15], \soff offen sc1
.endm

.macro PAD2 first, dst, src
.if \first
    v_lshlrev_b32 v[\dst], 16, v[\src]
    v_and_b32 v[\dst+1], 0xffff0000, v[\src]
.else
    s_nop 1
.endif
.endm

.macro ROW x, o, first
    v_lshlrev_b32 v[vT], 16, v[\x+4]
    v_and_b32 v[vT+1], 0xffff0000, v[\x+4]
    v_lshlrev_b32 v[vT+2], 16, v[\x+5]
    v_and_b32 v[vT+3], 0xffff0000, v[\x+5]
    v_lshlrev_b32 v[vT+4], 16, v[\x+6]
    v_and_b32 v[vT+5], 0xffff0000, v[\x+6]
    v_lshlrev_b32 v[vT+6], 16, v[\x+7]
    v_and_b32 v[vT+7], 0xffff0000, v[\x+7]
    v_dot2c_f32_bf16 v[vT], s20, v[\x]
    v_dot2c_f32_bf16 v[vT+1], s21, v[\x]
    v_dot2c_f32_bf16 v[vT+2], s20, v[\x+1]
    v_dot2c_f32_bf16 v[vT+3], s21, v[\x+1]
    v_dot2c_f32_bf16 v[vT+4], s20, v[\x+2]
    v_dot2c_f32_bf16 v[vT+5], s21, v[\x+2]
    v_dot2c_f32_bf16 v[vT+6], s20, v[\x+3]
    v_dot2c_f32_bf16 v[vT+7], s21, v[\x+3]
    v_cvt_pk_bf16_f32 v[vP], v[vT], v[vT+1]
    v_cvt_pk_bf16_f32 v[vP+1], v[vT+2], v[vT+3]
    v_readfirstlane_b32 s24, v[vP]
    v_cvt_pk_bf16_f32 v[vP+2], v[vT+4], v[vT+5]
    v_cvt_pk_bf16_f32 v[vP+3], v[vT+6], v[vT+7]
    s_lshl_b32 s24, s24, 16
    v_dot2_f32_bf16 v[\x], v[vP], v[vC], s24
    v_dot2_f32_bf16 v[\x+1], v[vP], v[vC+1], s24
    v_dot2_f32_bf16 v[\x+2], v[vP+1], v[vC], s24
    v_dot2_f32_bf16 v[\x+3], v[vP+1], v[vC+1], s24
    v_dot2_f32_bf16 v[\x+4], v[vP+2], v[vC], s24
    v_dot2_f32_bf16 v[\x+5], v[vP+2], v[vC+1], s24
    v_dot2_f32_bf16 v[\x+6], v[vP+3], v[vC], s24
    v_dot2_f32_bf16 v[\x+7], v[vP+3], v[vC+1], s24
    v_pk_mul_f32 v[vT:vT+1], v[\x:\x+1], v[\x:\x+1]
    v_pk_add_f32 v[vT+2:vT+3], v[\x:\x+1], v[\x+2:\x+3]
    v_pk_fma_f32 v[vT:vT+1], v[\x+2:\x+3], v[\x+2:\x+3], v[vT:vT+1]
    v_pk_add_f32 v[vT+2:vT+3], v[vT+2:vT+3], v[\x+4:\x+5]
    v_pk_fma_f32 v[vT:vT+1], v[\x+4:\x+5], v[\x+4:\x+5], v[vT:vT+1]
    v_pk_add_f32 v[vT+2:vT+3], v[vT+2:vT+3], v[\x+6:\x+7]
    v_pk_fma_f32 v[vT:vT+1], v[\x+6:\x+7], v[\x+6:\x+7], v[vT:vT+1]
    v_add_f32 v[vR], v[vT+2], v[vT+3]
    v_add_f32 v[vR+1], v[vT], v[vT+1]
    PAD2 \first, vG, vG+4
    v_permlane32_swap_b32 v[vR], v[vR+1]
    v_add_f32 v[vR], v[vR], v[vR+1]
    PAD2 \first, vG+2, vG+5
    v_add_f32_dpp v[vR], v[vR], v[vR] quad_perm:[1,0,3,2] row_mask:0xf bank_mask:0xf
    PAD2 \first, vG+4, vG+6
    v_add_f32_dpp v[vR], v[vR], v[vR] quad_perm:[2,3,0,1] row_mask:0xf bank_mask:0xf
    PAD2 \first, vG+6, vG+7
    v_add_f32_dpp v[vR], v[vR], v[vR] row_half_mirror row_mask:0xf bank_mask:0xf
    PAD2 \first, vB, vB+4
    v_add_f32_dpp v[vR], v[vR], v[vR] row_mirror row_mask:0xf bank_mask:0xf
    PAD2 \first, vB+2, vB+5
    v_add_f32_dpp v[vR], v[vR], v[vR] row_bcast:15 row_mask:0xa bank_mask:0xf
    s_nop 0
    v_readlane_b32 s25, v[vR], 31
    v_readlane_b32 s26, v[vR], 63
    s_nop 0
    v_mul_f32 v[vR], s25, v[vC+2]
    v_mul_f32 v[vR+1], s26, v[vC+2]
    v_fma_f32 v[vR+1], -v[vR], v[vR], v[vR+1]
    v_cvt_pk_bf16_f32 v[vR+1], 0, v[vR+1]
    v_add_f32 v[vR+1], s23, v[vR+1]
    v_cvt_pk_bf16_f32 v[vR+1], 0, v[vR+1]
    v_sqrt_f32 v[vR+1], v[vR+1]
    v_sub_f32 v[vR], s24, v[vR]
    v_cvt_pk_bf16_f32 v[vR+1], 0, v[vR+1]
    v_cvt_pk_bf16_f32 v[vR], 0, v[vR]
    v_rcp_f32 v[vR+2], v[vR+1]
    v_sub_f32 v[vR], s24, v[vR]
    v_mul_f32 v[vR+3], v[vR], v[vR+2]
.if \first
    PAD2 1, vB+4, vB+6
    PAD2 1, vB+6, vB+7
.endif
    v_pk_fma_f32 v[\x:\x+1], v[\x:\x+1], v[vR+2:vR+3], v[vR+2:vR+3] op_sel:[0,0,1] op_sel_hi:[1,0,1] neg_lo:[0,1,0] neg_hi:[0,1,0]
    v_pk_fma_f32 v[\x+2:\x+3], v[\x+2:\x+3], v[vR+2:vR+3], v[vR+2:vR+3] op_sel:[0,0,1] op_sel_hi:[1,0,1] neg_lo:[0,1,0] neg_hi:[0,1,0]
    v_pk_fma_f32 v[\x+4:\x+5], v[\x+4:\x+5], v[vR+2:vR+3], v[vR+2:vR+3] op_sel:[0,0,1] op_sel_hi:[1,0,1] neg_lo:[0,1,0] neg_hi:[0,1,0]
    v_pk_fma_f32 v[\x+6:\x+7], v[\x+6:\x+7], v[vR+2:vR+3], v[vR+2:vR+3] op_sel:[0,0,1] op_sel_hi:[1,0,1] neg_lo:[0,1,0] neg_hi:[0,1,0]
    v_pk_fma_f32 v[\x:\x+1], v[\x:\x+1], v[vG:vG+1], v[vB:vB+1]
    v_pk_fma_f32 v[\x+2:\x+3], v[\x+2:\x+3], v[vG+2:vG+3], v[vB+2:vB+3]
    v_pk_fma_f32 v[\x+4:\x+5], v[\x+4:\x+5], v[vG+4:vG+5], v[vB+4:vB+5]
    v_pk_fma_f32 v[\x+6:\x+7], v[\x+6:\x+7], v[vG+6:vG+7], v[vB+6:vB+7]
    v_cvt_pk_bf16_f32 v[\o], v[\x], v[\x+1]
    v_cvt_pk_bf16_f32 v[\o+1], v[\x+2], v[\x+3]
    v_cvt_pk_bf16_f32 v[\o+2], v[\x+4], v[\x+5]
    v_cvt_pk_bf16_f32 v[\o+3], v[\x+6], v[\x+7]
.endm

.macro MAPSTEPS
    s_lshr_b32 s36, s34, 4
    s_add_u32 s36, s36, s2
    s_bfe_u32 s22, s36, 0x10001
    s_lshl_b32 s22, s22, 7
    s_bfe_u32 s3, s36, 0x10000
    s_lshl_b32 s3, s3, 8
    s_or_b32 s22, s22, s3
    s_bfe_u32 s3, s36, 0x10002
    s_lshl_b32 s3, s3, 1
    s_or_b32 s22, s22, s3
    s_or_b32 s22, s22, s37
    s_lshr_b32 s3, s34, 8
    s_xor_b32 s3, s3, s34
    s_and_b32 s3, s3, 2
    s_or_b32 s3, s3, s38
    s_cselect_b32 s3, 16, 0
    s_cselect_b32 s36, s12, s4
    s_lshr_b32 s34, s34, s3
    s_and_b32 s34, s34, 2
    s_xor_b32 s22, s22, s34
    s_xor_b32 s3, s22, 2
    s_lshr_b32 s36, s36, 12
    s_sub_u32 s22, s22, s36
    s_sub_u32 s3, s3, s36
    s_and_b32 s22, s22, 0x1ff
    s_and_b32 s3, s3, 0x1ff
    s_lshl_b32 s22, s22, 12
    s_lshl_b32 s3, s3, 12
    v_add_u32 v[vODD], s3, v[vEVEN]
    v_add_u32 v[vEVEN], s22, v[vEVEN]
    LOADROW vS0, vODD, s43
.endm

.globl standalone__deepnorm__sampling_kernel
.p2align 8
.type standalone__deepnorm__sampling_kernel,@function
standalone__deepnorm__sampling_kernel:
    s_load_dwordx2 s[4:5], s[0:1], 0
    s_load_dwordx2 s[8:9], s[0:1], 8
    v_readfirstlane_b32 s34, v0
    s_sub_u32 s35, s2, 1
    s_load_dwordx2 s[12:13], s[0:1], 40
    s_load_dwordx2 s[32:33], s[0:1], 48
    s_load_dwordx4 s[16:19], s[0:1], 16
    s_load_dwordx2 s[28:29], s[0:1], 32
    s_and_b32 s36, s35, 0xff27
    s_or_b32 s36, s36, s34
    s_cbranch_scc1 L_main
    s_bfe_u32 s34, s35, 0x20003
    s_lshr_b32 s35, s35, 6
    s_lshl2_add_u32 s34, s35, s34
    s_cmpk_ge_u32 s34, 9
    s_mov_b32 s36, 1
    s_cbranch_scc1 L_main
    s_mul_i32 s35, s34, 86
    s_lshr_b32 s35, s35, 8
    s_mul_i32 s3, s35, 3
    s_sub_u32 s26, s34, s3
    s_mul_i32 s25, s35, 0x14900
    s_add_u32 s25, s25, 0x800000
    s_getreg_b32 s21, hwreg(HW_REG_XCC_ID, 0, 3)
    s_sub_u32 s20, s21, s2
    s_and_b32 s20, s20, 7
    s_lshl_b32 s20, s20, 4
    s_cmp_eq_u32 s34, 0
    s_cselect_b32 s20, s20, 0
    s_cmp_eq_u32 s26, 0
    s_waitcnt lgkmcnt(0)
    s_cselect_b64 s[36:37], s[4:5], s[8:9]
    s_cmp_eq_u32 s26, 2
    s_cselect_b64 s[36:37], s[12:13], s[36:37]
    s_add_u32 s36, s36, s25
    s_addc_u32 s37, s37, 0
    s_bitset0_b32 s36, 13
    s_load_dword s48, s[36:37], 0
    s_load_dword s49, s[36:37], 0x2000
    s_waitcnt lgkmcnt(1)
    s_lshr_b32 s21, s21, 2
    s_bitset1_b32 s20, 24
    s_lshl_b32 s34, s26, 3
    s_getreg_b32 s50, hwreg(HW_REG_IB_STS, 8, 4)
    s_cmp_eq_u32 s50, 0
    s_cselect_b32 s50, 1, 0
    s_xor_b32 s50, s50, s21
    s_lshl_b32 s50, s50, s34
    s_or_b32 s50, s50, s20
    s_atomic_add s50, s[32:33], 60
    s_atomic_add s50, s[32:33], 124
    s_atomic_add s50, s[32:33], 188
    s_mov_b32 s36, 0
L_main:
    s_cmpk_ge_u32 s2, 512
    s_cbranch_scc1 L_end
    s_and_b32 s27, s2, 7
    s_lshl_b32 s27, s27, 2
    s_bfe_u32 s3, s2, 0x20003
    s_or_b32 s27, s27, s3
    s_andn2_b32 s3, s2, 31
    s_or_b32 s27, s27, s3
    s_lshl_b32 s27, s27, 12
    v_lshlrev_b32 v[vEVEN], 4, v0
    v_add_u32 v[vOFF], s27, v[vEVEN]
    v_and_b32 v[vLANE], 0x3ff, v[vEVEN]
    s_mov_b32 s6, 0x1000000
    s_mov_b32 s7, 0x20000
    s_mov_b32 s10, 0x1000000
    s_mov_b32 s11, 0x20000
    s_mov_b32 s41, 0x200000
    v_mov_b32 v[vZERO], 0
    s_cmp_eq_u32 s36, 0
    s_cbranch_scc1 L_go
    s_waitcnt lgkmcnt(0)
L_go:
    LOADROW vS0, vOFF, 0
    global_load_dwordx4 v[vG+4:vG+7], v[vLANE], s[16:17]
    global_load_dwordx4 v[vB+4:vB+7], v[vLANE], s[18:19]
    global_load_ushort v[vC+3], v[vZERO], s[28:29]
    LOADROW vS1, vOFF, s41
    s_mov_b32 s14, 0x1000000
    s_mov_b32 s15, 0x20000
    s_mov_b32 s42, 0x400000
    s_mov_b32 s43, 0x600000
    s_mov_b32 s44, 0x800000
    s_mov_b32 s45, 0xa00000
    s_mov_b32 s46, 0xc00000
    s_mov_b32 s47, 0xe00000
    s_mov_b32 s23, 0x3727c5ac
    v_mov_b32 v[vC], 0xbf80
    v_mov_b32 v[vC+1], 0xbf800000
    v_mov_b32 v[vC+2], 0x3b000000
    v_mov_b32 v[vODD], v[vOFF]
    s_bfe_u32 s37, s2, 0x10004
    s_bfe_u32 s3, s2, 0x10003
    s_lshl_b32 s3, s3, 2
    s_or_b32 s37, s37, s3
    s_bfe_u32 s3, s2, 0x40005
    s_lshl_b32 s3, s3, 3
    s_or_b32 s37, s37, s3
    s_xor_b32 s38, s4, s8
    s_and_b32 s38, s38, 0x3fff
    s_waitcnt vmcnt(5)
    LOADROW vS2, vOFF, s42
    s_waitcnt vmcnt(4)
    v_readfirstlane_b32 s20, v[vC+3]
    s_lshl_b32 s21, s20, 16
    ROW vS0, vH0, 1
    s_load_dword s34, s[32:33], 60
    s_waitcnt vmcnt(2)
    s_mov_b32 s35, 0
    s_waitcnt lgkmcnt(0)
    s_cmp_ge_u32 s34, 0x9000000
    s_cbranch_scc0 L_later
    MAPSTEPS
    s_mov_b32 s35, 1
L_later:
    s_load_dword s34, s[32:33], 124
    ROW vS1, vH1, 0
    s_cmp_eq_u32 s35, 0
    s_cbranch_scc1 L_retry
L_mapped:
    s_waitcnt vmcnt(2)
    LOADROW vS1, vEVEN, s44
    STOREROW vH0, vOFF, 0
    ROW vS2, vH2, 0
    s_waitcnt vmcnt(3)
    LOADROW vS2, vODD, s45
    STOREROW vH1, vOFF, s41
    ROW vS0, vP, 0
    STOREROW vP, vODD, s43
    s_waitcnt vmcnt(5)
    LOADROW vS0, vEVEN, s46
    STOREROW vH2, vOFF, s42
    ROW vS1, vP, 0
    STOREROW vP, vEVEN, s44
    s_waitcnt vmcnt(6)
    LOADROW vS1, vODD, s47
    ROW vS2, vP, 0
    STOREROW vP, vODD, s45
    s_waitcnt vmcnt(5)
    ROW vS0, vP, 0
    STOREROW vP, vEVEN, s46
    s_waitcnt vmcnt(2)
    ROW vS1, vP, 0
    STOREROW vP, vODD, s47
L_end:
    s_endpgm

L_retry:
    s_waitcnt lgkmcnt(0)
    s_cmp_ge_u32 s34, 0x9000000
    s_cbranch_scc1 L_have
    s_load_dword s34, s[32:33], 188
    s_movk_i32 s36, 0x7fff
    s_waitcnt lgkmcnt(0)
L_poll:
    s_cmp_ge_u32 s34, 0x9000000
    s_cbranch_scc1 L_have
    s_sub_u32 s36, s36, 1
    s_cbranch_scc1 L_have
    global_load_dword v[vODD], v[vZERO], s[32:33] offset:60 sc1
    s_waitcnt vmcnt(0)
    v_readfirstlane_b32 s34, v[vODD]
    s_branch L_poll
L_have:
    MAPSTEPS
    s_branch L_mapped

.section .rodata,"a"
.p2align 6
.amdhsa_kernel standalone__deepnorm__sampling_kernel
  .amdhsa_next_free_vgpr 78
  .amdhsa_next_free_sgpr 52
  .amdhsa_accum_offset 80
  .amdhsa_group_segment_fixed_size 0
  .amdhsa_kernarg_size 64
  .amdhsa_user_sgpr_count 2
  .amdhsa_user_sgpr_kernarg_segment_ptr 1
  .amdhsa_system_sgpr_workgroup_id_x 1
  .amdhsa_float_denorm_mode_32 3
.end_amdhsa_kernel
```

```asm
; @launch grid=(512,1,1) block=(256,1,1) lds=0
.amdgcn_target "amdgcn-amd-amdhsa--gfx950"
.text

.set vOFF, 0
.set vLANE, 1
.set vS0, 2
.set vS1, 10
.set vS2, 18
.set vG, 26
.set vB, 34
.set vT, 42
.set vP, 50
.set vC, 54
.set vR, 58
.set vEVEN, 62
.set vODD, 63
.set vZERO, 64
.set vH0, 66
.set vH1, 70
.set vH2, 74

.macro LOADROW slot, voff, soff
    buffer_load_dwordx4 v[\slot:\slot+3], v[\voff], s[4:7], \soff offen nt
    buffer_load_dwordx4 v[\slot+4:\slot+7], v[\voff], s[8:11], \soff offen nt
.endm

.macro STOREROW row, voff, soff
    buffer_store_dwordx4 v[\row:\row+3], v[\voff], s[12:15], \soff offen sc1
.endm

.macro PAD2 first, dst, src
.if \first
    v_lshlrev_b32 v[\dst], 16, v[\src]
    v_and_b32 v[\dst+1], 0xffff0000, v[\src]
.else
    s_nop 1
.endif
.endm

.macro ROW x, o, first
    v_lshlrev_b32 v[vT], 16, v[\x+4]
    v_and_b32 v[vT+1], 0xffff0000, v[\x+4]
    v_lshlrev_b32 v[vT+2], 16, v[\x+5]
    v_and_b32 v[vT+3], 0xffff0000, v[\x+5]
    v_lshlrev_b32 v[vT+4], 16, v[\x+6]
    v_and_b32 v[vT+5], 0xffff0000, v[\x+6]
    v_lshlrev_b32 v[vT+6], 16, v[\x+7]
    v_and_b32 v[vT+7], 0xffff0000, v[\x+7]
    v_dot2c_f32_bf16 v[vT], s20, v[\x]
    v_dot2c_f32_bf16 v[vT+1], s21, v[\x]
    v_dot2c_f32_bf16 v[vT+2], s20, v[\x+1]
    v_dot2c_f32_bf16 v[vT+3], s21, v[\x+1]
    v_dot2c_f32_bf16 v[vT+4], s20, v[\x+2]
    v_dot2c_f32_bf16 v[vT+5], s21, v[\x+2]
    v_dot2c_f32_bf16 v[vT+6], s20, v[\x+3]
    v_dot2c_f32_bf16 v[vT+7], s21, v[\x+3]
    v_cvt_pk_bf16_f32 v[vP], v[vT], v[vT+1]
    v_cvt_pk_bf16_f32 v[vP+1], v[vT+2], v[vT+3]
    v_readfirstlane_b32 s24, v[vP]
    v_cvt_pk_bf16_f32 v[vP+2], v[vT+4], v[vT+5]
    v_cvt_pk_bf16_f32 v[vP+3], v[vT+6], v[vT+7]
    s_lshl_b32 s24, s24, 16
    v_dot2_f32_bf16 v[\x], v[vP], v[vC], s24
    v_dot2_f32_bf16 v[\x+1], v[vP], v[vC+1], s24
    v_dot2_f32_bf16 v[\x+2], v[vP+1], v[vC], s24
    v_dot2_f32_bf16 v[\x+3], v[vP+1], v[vC+1], s24
    v_dot2_f32_bf16 v[\x+4], v[vP+2], v[vC], s24
    v_dot2_f32_bf16 v[\x+5], v[vP+2], v[vC+1], s24
    v_dot2_f32_bf16 v[\x+6], v[vP+3], v[vC], s24
    v_dot2_f32_bf16 v[\x+7], v[vP+3], v[vC+1], s24
    v_pk_mul_f32 v[vT:vT+1], v[\x:\x+1], v[\x:\x+1]
    v_pk_add_f32 v[vT+2:vT+3], v[\x:\x+1], v[\x+2:\x+3]
    v_pk_fma_f32 v[vT:vT+1], v[\x+2:\x+3], v[\x+2:\x+3], v[vT:vT+1]
    v_pk_add_f32 v[vT+2:vT+3], v[vT+2:vT+3], v[\x+4:\x+5]
    v_pk_fma_f32 v[vT:vT+1], v[\x+4:\x+5], v[\x+4:\x+5], v[vT:vT+1]
    v_pk_add_f32 v[vT+2:vT+3], v[vT+2:vT+3], v[\x+6:\x+7]
    v_pk_fma_f32 v[vT:vT+1], v[\x+6:\x+7], v[\x+6:\x+7], v[vT:vT+1]
    v_add_f32 v[vR], v[vT+2], v[vT+3]
    v_add_f32 v[vR+1], v[vT], v[vT+1]
    PAD2 \first, vG, vG+4
    v_permlane32_swap_b32 v[vR], v[vR+1]
    v_add_f32 v[vR], v[vR], v[vR+1]
    PAD2 \first, vG+2, vG+5
    v_add_f32_dpp v[vR], v[vR], v[vR] quad_perm:[1,0,3,2] row_mask:0xf bank_mask:0xf
    PAD2 \first, vG+4, vG+6
    v_add_f32_dpp v[vR], v[vR], v[vR] quad_perm:[2,3,0,1] row_mask:0xf bank_mask:0xf
    PAD2 \first, vG+6, vG+7
    v_add_f32_dpp v[vR], v[vR], v[vR] row_half_mirror row_mask:0xf bank_mask:0xf
    PAD2 \first, vB, vB+4
    v_add_f32_dpp v[vR], v[vR], v[vR] row_mirror row_mask:0xf bank_mask:0xf
    PAD2 \first, vB+2, vB+5
    v_add_f32_dpp v[vR], v[vR], v[vR] row_bcast:15 row_mask:0xa bank_mask:0xf
    s_nop 0
    v_readlane_b32 s25, v[vR], 31
    v_readlane_b32 s26, v[vR], 63
    s_nop 0
    v_mul_f32 v[vR], s25, v[vC+2]
    v_mul_f32 v[vR+1], s26, v[vC+2]
    v_fma_f32 v[vR+1], -v[vR], v[vR], v[vR+1]
    v_cvt_pk_bf16_f32 v[vR+1], 0, v[vR+1]
    v_add_f32 v[vR+1], s23, v[vR+1]
    v_cvt_pk_bf16_f32 v[vR+1], 0, v[vR+1]
    v_sqrt_f32 v[vR+1], v[vR+1]
    v_sub_f32 v[vR], s24, v[vR]
    v_cvt_pk_bf16_f32 v[vR+1], 0, v[vR+1]
    v_cvt_pk_bf16_f32 v[vR], 0, v[vR]
    v_rcp_f32 v[vR+2], v[vR+1]
    v_sub_f32 v[vR], s24, v[vR]
    v_mul_f32 v[vR+3], v[vR], v[vR+2]
.if \first
    PAD2 1, vB+4, vB+6
    PAD2 1, vB+6, vB+7
.endif
    v_pk_fma_f32 v[\x:\x+1], v[\x:\x+1], v[vR+2:vR+3], v[vR+2:vR+3] op_sel:[0,0,1] op_sel_hi:[1,0,1] neg_lo:[0,1,0] neg_hi:[0,1,0]
    v_pk_fma_f32 v[\x+2:\x+3], v[\x+2:\x+3], v[vR+2:vR+3], v[vR+2:vR+3] op_sel:[0,0,1] op_sel_hi:[1,0,1] neg_lo:[0,1,0] neg_hi:[0,1,0]
    v_pk_fma_f32 v[\x+4:\x+5], v[\x+4:\x+5], v[vR+2:vR+3], v[vR+2:vR+3] op_sel:[0,0,1] op_sel_hi:[1,0,1] neg_lo:[0,1,0] neg_hi:[0,1,0]
    v_pk_fma_f32 v[\x+6:\x+7], v[\x+6:\x+7], v[vR+2:vR+3], v[vR+2:vR+3] op_sel:[0,0,1] op_sel_hi:[1,0,1] neg_lo:[0,1,0] neg_hi:[0,1,0]
    v_pk_fma_f32 v[\x:\x+1], v[\x:\x+1], v[vG:vG+1], v[vB:vB+1]
    v_pk_fma_f32 v[\x+2:\x+3], v[\x+2:\x+3], v[vG+2:vG+3], v[vB+2:vB+3]
    v_pk_fma_f32 v[\x+4:\x+5], v[\x+4:\x+5], v[vG+4:vG+5], v[vB+4:vB+5]
    v_pk_fma_f32 v[\x+6:\x+7], v[\x+6:\x+7], v[vG+6:vG+7], v[vB+6:vB+7]
    v_cvt_pk_bf16_f32 v[\o], v[\x], v[\x+1]
    v_cvt_pk_bf16_f32 v[\o+1], v[\x+2], v[\x+3]
    v_cvt_pk_bf16_f32 v[\o+2], v[\x+4], v[\x+5]
    v_cvt_pk_bf16_f32 v[\o+3], v[\x+6], v[\x+7]
.endm

.macro MAPSTEPS
    s_lshr_b32 s36, s34, 4
    s_add_u32 s36, s36, s2
    s_bfe_u32 s22, s36, 0x10001
    s_lshl_b32 s22, s22, 7
    s_bfe_u32 s3, s36, 0x10000
    s_lshl_b32 s3, s3, 8
    s_or_b32 s22, s22, s3
    s_bfe_u32 s3, s36, 0x10002
    s_lshl_b32 s3, s3, 1
    s_or_b32 s22, s22, s3
    s_or_b32 s22, s22, s37
    s_lshr_b32 s3, s34, 8
    s_xor_b32 s3, s3, s34
    s_and_b32 s3, s3, 2
    s_or_b32 s3, s3, s38
    s_cselect_b32 s3, 16, 0
    s_cselect_b32 s36, s12, s4
    s_lshr_b32 s34, s34, s3
    s_and_b32 s34, s34, 2
    s_xor_b32 s22, s22, s34
    s_xor_b32 s3, s22, 2
    s_lshr_b32 s36, s36, 12
    s_sub_u32 s22, s22, s36
    s_sub_u32 s3, s3, s36
    s_and_b32 s22, s22, 0x1ff
    s_and_b32 s3, s3, 0x1ff
    s_lshl_b32 s22, s22, 12
    s_lshl_b32 s3, s3, 12
    v_add_u32 v[vODD], s3, v[vEVEN]
    v_add_u32 v[vEVEN], s22, v[vEVEN]
    LOADROW vS0, vODD, s43
.endm

.globl standalone__deepnorm__sampling_kernel
.p2align 8
.type standalone__deepnorm__sampling_kernel,@function
standalone__deepnorm__sampling_kernel:
    s_load_dwordx2 s[4:5], s[0:1], 0
    s_load_dwordx2 s[8:9], s[0:1], 8
    v_readfirstlane_b32 s34, v0
    s_sub_u32 s35, s2, 1
    s_load_dwordx2 s[12:13], s[0:1], 40
    s_load_dwordx2 s[32:33], s[0:1], 48
    s_load_dwordx4 s[16:19], s[0:1], 16
    s_load_dwordx2 s[28:29], s[0:1], 32
    s_and_b32 s36, s35, 0xff27
    s_or_b32 s36, s36, s34
    s_cbranch_scc1 L_main
    s_bfe_u32 s34, s35, 0x20003
    s_lshr_b32 s35, s35, 6
    s_lshl2_add_u32 s34, s35, s34
    s_cmpk_ge_u32 s34, 9
    s_mov_b32 s36, 1
    s_cbranch_scc1 L_main
    s_mul_i32 s35, s34, 86
    s_lshr_b32 s35, s35, 8
    s_mul_i32 s3, s35, 3
    s_sub_u32 s26, s34, s3
    s_mul_i32 s25, s35, 0x14900
    s_add_u32 s25, s25, 0x800000
    s_getreg_b32 s21, hwreg(HW_REG_XCC_ID, 0, 3)
    s_sub_u32 s20, s21, s2
    s_and_b32 s20, s20, 7
    s_lshl_b32 s20, s20, 4
    s_cmp_eq_u32 s34, 0
    s_cselect_b32 s20, s20, 0
    s_cmp_eq_u32 s26, 0
    s_waitcnt lgkmcnt(0)
    s_cselect_b64 s[36:37], s[4:5], s[8:9]
    s_cmp_eq_u32 s26, 2
    s_cselect_b64 s[36:37], s[12:13], s[36:37]
    s_add_u32 s36, s36, s25
    s_addc_u32 s37, s37, 0
    s_bitset0_b32 s36, 13
    s_load_dword s48, s[36:37], 0
    s_load_dword s49, s[36:37], 0x2000
    s_waitcnt lgkmcnt(1)
    s_lshr_b32 s21, s21, 2
    s_bitset1_b32 s20, 24
    s_lshl_b32 s34, s26, 3
    s_getreg_b32 s50, hwreg(HW_REG_IB_STS, 8, 4)
    s_cmp_eq_u32 s50, 0
    s_cselect_b32 s50, 1, 0
    s_xor_b32 s50, s50, s21
    s_lshl_b32 s50, s50, s34
    s_or_b32 s50, s50, s20
    s_atomic_add s50, s[32:33], 188
    s_atomic_add s50, s[32:33], 60
    s_atomic_add s50, s[32:33], 124
    s_mov_b32 s36, 0
L_main:
    s_cmpk_ge_u32 s2, 512
    s_cbranch_scc1 L_end
    s_and_b32 s27, s2, 7
    s_lshl_b32 s27, s27, 2
    s_bfe_u32 s3, s2, 0x20003
    s_or_b32 s27, s27, s3
    s_andn2_b32 s3, s2, 31
    s_or_b32 s27, s27, s3
    s_lshl_b32 s27, s27, 12
    v_lshlrev_b32 v[vEVEN], 4, v0
    v_add_u32 v[vOFF], s27, v[vEVEN]
    v_and_b32 v[vLANE], 0x3ff, v[vEVEN]
    s_mov_b32 s6, 0x1000000
    s_mov_b32 s7, 0x20000
    s_mov_b32 s10, 0x1000000
    s_mov_b32 s11, 0x20000
    s_mov_b32 s41, 0x200000
    v_mov_b32 v[vZERO], 0
    s_cmp_eq_u32 s36, 0
    s_cbranch_scc1 L_go
    s_waitcnt lgkmcnt(0)
L_go:
    LOADROW vS0, vOFF, 0
    global_load_dwordx4 v[vG+4:vG+7], v[vLANE], s[16:17]
    global_load_dwordx4 v[vB+4:vB+7], v[vLANE], s[18:19]
    global_load_ushort v[vC+3], v[vZERO], s[28:29]
    LOADROW vS1, vOFF, s41
    s_mov_b32 s14, 0x1000000
    s_mov_b32 s15, 0x20000
    s_mov_b32 s42, 0x400000
    s_mov_b32 s43, 0x600000
    s_mov_b32 s44, 0x800000
    s_mov_b32 s45, 0xa00000
    s_mov_b32 s46, 0xc00000
    s_mov_b32 s47, 0xe00000
    s_mov_b32 s23, 0x3727c5ac
    v_mov_b32 v[vC], 0xbf80
    v_mov_b32 v[vC+1], 0xbf800000
    v_mov_b32 v[vC+2], 0x3b000000
    v_mov_b32 v[vODD], v[vOFF]
    s_bfe_u32 s37, s2, 0x10004
    s_bfe_u32 s3, s2, 0x10003
    s_lshl_b32 s3, s3, 2
    s_or_b32 s37, s37, s3
    s_bfe_u32 s3, s2, 0x40005
    s_lshl_b32 s3, s3, 3
    s_or_b32 s37, s37, s3
    s_xor_b32 s38, s4, s8
    s_and_b32 s38, s38, 0x3fff
    s_waitcnt vmcnt(5)
    LOADROW vS2, vOFF, s42
    s_waitcnt vmcnt(4)
    v_readfirstlane_b32 s20, v[vC+3]
    s_lshl_b32 s21, s20, 16
    ROW vS0, vH0, 1
    s_load_dword s34, s[32:33], 188
    s_waitcnt vmcnt(2)
    s_mov_b32 s35, 0
    s_waitcnt lgkmcnt(0)
    s_cmp_ge_u32 s34, 0x9000000
    s_cbranch_scc0 L_later
    MAPSTEPS
    s_mov_b32 s35, 1
L_later:
    s_load_dword s34, s[32:33], 60
    ROW vS1, vH1, 0
    s_cmp_eq_u32 s35, 0
    s_cbranch_scc1 L_retry
L_mapped:
    s_waitcnt vmcnt(2)
    LOADROW vS1, vEVEN, s44
    STOREROW vH0, vOFF, 0
    ROW vS2, vH2, 0
    s_waitcnt vmcnt(3)
    LOADROW vS2, vODD, s45
    STOREROW vH1, vOFF, s41
    ROW vS0, vP, 0
    STOREROW vP, vODD, s43
    s_waitcnt vmcnt(5)
    LOADROW vS0, vEVEN, s46
    STOREROW vH2, vOFF, s42
    ROW vS1, vP, 0
    STOREROW vP, vEVEN, s44
    s_waitcnt vmcnt(6)
    LOADROW vS1, vODD, s47
    ROW vS2, vP, 0
    STOREROW vP, vODD, s45
    s_waitcnt vmcnt(5)
    ROW vS0, vP, 0
    STOREROW vP, vEVEN, s46
    s_waitcnt vmcnt(2)
    ROW vS1, vP, 0
    STOREROW vP, vODD, s47
L_end:
    s_endpgm

L_retry:
    s_waitcnt lgkmcnt(0)
    s_cmp_ge_u32 s34, 0x9000000
    s_cbranch_scc1 L_have
    s_load_dword s34, s[32:33], 124
    s_movk_i32 s36, 0x7fff
    s_waitcnt lgkmcnt(0)
L_poll:
    s_cmp_ge_u32 s34, 0x9000000
    s_cbranch_scc1 L_have
    s_sub_u32 s36, s36, 1
    s_cbranch_scc1 L_have
    global_load_dword v[vODD], v[vZERO], s[32:33] offset:188 sc1
    s_waitcnt vmcnt(0)
    v_readfirstlane_b32 s34, v[vODD]
    s_branch L_poll
L_have:
    MAPSTEPS
    s_branch L_mapped

.section .rodata,"a"
.p2align 6
.amdhsa_kernel standalone__deepnorm__sampling_kernel
  .amdhsa_next_free_vgpr 78
  .amdhsa_next_free_sgpr 52
  .amdhsa_accum_offset 80
  .amdhsa_group_segment_fixed_size 0
  .amdhsa_kernarg_size 64
  .amdhsa_user_sgpr_count 2
  .amdhsa_user_sgpr_kernarg_segment_ptr 1
  .amdhsa_system_sgpr_workgroup_id_x 1
  .amdhsa_float_denorm_mode_32 3
.end_amdhsa_kernel
```

```asm
; @launch grid=(512,1,1) block=(256,1,1) lds=0
.amdgcn_target "amdgcn-amd-amdhsa--gfx950"
.text

.set vOFF, 0
.set vLANE, 1
.set vS0, 2
.set vS1, 10
.set vS2, 18
.set vG, 26
.set vB, 34
.set vT, 42
.set vP, 50
.set vC, 54
.set vR, 58
.set vEVEN, 62
.set vODD, 63
.set vZERO, 64
.set vH0, 66
.set vH1, 70
.set vH2, 74

.macro LOADROW slot, voff, soff
    buffer_load_dwordx4 v[\slot:\slot+3], v[\voff], s[4:7], \soff offen nt
    buffer_load_dwordx4 v[\slot+4:\slot+7], v[\voff], s[8:11], \soff offen nt
.endm

.macro STOREROW row, voff, soff
    buffer_store_dwordx4 v[\row:\row+3], v[\voff], s[12:15], \soff offen sc0 sc1
.endm

.macro PAD2 first, dst, src
.if \first
    v_lshlrev_b32 v[\dst], 16, v[\src]
    v_and_b32 v[\dst+1], 0xffff0000, v[\src]
.else
    s_nop 1
.endif
.endm

.macro ROW x, o, first
    v_lshlrev_b32 v[vT], 16, v[\x+4]
    v_and_b32 v[vT+1], 0xffff0000, v[\x+4]
    v_lshlrev_b32 v[vT+2], 16, v[\x+5]
    v_and_b32 v[vT+3], 0xffff0000, v[\x+5]
    v_lshlrev_b32 v[vT+4], 16, v[\x+6]
    v_and_b32 v[vT+5], 0xffff0000, v[\x+6]
    v_lshlrev_b32 v[vT+6], 16, v[\x+7]
    v_and_b32 v[vT+7], 0xffff0000, v[\x+7]
    v_dot2c_f32_bf16 v[vT], s20, v[\x]
    v_dot2c_f32_bf16 v[vT+1], s21, v[\x]
    v_dot2c_f32_bf16 v[vT+2], s20, v[\x+1]
    v_dot2c_f32_bf16 v[vT+3], s21, v[\x+1]
    v_dot2c_f32_bf16 v[vT+4], s20, v[\x+2]
    v_dot2c_f32_bf16 v[vT+5], s21, v[\x+2]
    v_dot2c_f32_bf16 v[vT+6], s20, v[\x+3]
    v_dot2c_f32_bf16 v[vT+7], s21, v[\x+3]
    v_cvt_pk_bf16_f32 v[vP], v[vT], v[vT+1]
    v_cvt_pk_bf16_f32 v[vP+1], v[vT+2], v[vT+3]
    v_readfirstlane_b32 s24, v[vP]
    v_cvt_pk_bf16_f32 v[vP+2], v[vT+4], v[vT+5]
    v_cvt_pk_bf16_f32 v[vP+3], v[vT+6], v[vT+7]
    s_lshl_b32 s24, s24, 16
    v_dot2_f32_bf16 v[\x], v[vP], v[vC], s24
    v_dot2_f32_bf16 v[\x+1], v[vP], v[vC+1], s24
    v_dot2_f32_bf16 v[\x+2], v[vP+1], v[vC], s24
    v_dot2_f32_bf16 v[\x+3], v[vP+1], v[vC+1], s24
    v_dot2_f32_bf16 v[\x+4], v[vP+2], v[vC], s24
    v_dot2_f32_bf16 v[\x+5], v[vP+2], v[vC+1], s24
    v_dot2_f32_bf16 v[\x+6], v[vP+3], v[vC], s24
    v_dot2_f32_bf16 v[\x+7], v[vP+3], v[vC+1], s24
    v_pk_mul_f32 v[vT:vT+1], v[\x:\x+1], v[\x:\x+1]
    v_pk_add_f32 v[vT+2:vT+3], v[\x:\x+1], v[\x+2:\x+3]
    v_pk_fma_f32 v[vT:vT+1], v[\x+2:\x+3], v[\x+2:\x+3], v[vT:vT+1]
    v_pk_add_f32 v[vT+2:vT+3], v[vT+2:vT+3], v[\x+4:\x+5]
    v_pk_fma_f32 v[vT:vT+1], v[\x+4:\x+5], v[\x+4:\x+5], v[vT:vT+1]
    v_pk_add_f32 v[vT+2:vT+3], v[vT+2:vT+3], v[\x+6:\x+7]
    v_pk_fma_f32 v[vT:vT+1], v[\x+6:\x+7], v[\x+6:\x+7], v[vT:vT+1]
    v_add_f32 v[vR], v[vT+2], v[vT+3]
    v_add_f32 v[vR+1], v[vT], v[vT+1]
    PAD2 \first, vG, vG+4
    v_permlane32_swap_b32 v[vR], v[vR+1]
    v_add_f32 v[vR], v[vR], v[vR+1]
    PAD2 \first, vG+2, vG+5
    v_add_f32_dpp v[vR], v[vR], v[vR] quad_perm:[1,0,3,2] row_mask:0xf bank_mask:0xf
    PAD2 \first, vG+4, vG+6
    v_add_f32_dpp v[vR], v[vR], v[vR] quad_perm:[2,3,0,1] row_mask:0xf bank_mask:0xf
    PAD2 \first, vG+6, vG+7
    v_add_f32_dpp v[vR], v[vR], v[vR] row_half_mirror row_mask:0xf bank_mask:0xf
    PAD2 \first, vB, vB+4
    v_add_f32_dpp v[vR], v[vR], v[vR] row_mirror row_mask:0xf bank_mask:0xf
    PAD2 \first, vB+2, vB+5
    v_add_f32_dpp v[vR], v[vR], v[vR] row_bcast:15 row_mask:0xa bank_mask:0xf
    s_nop 0
    v_readlane_b32 s25, v[vR], 31
    v_readlane_b32 s26, v[vR], 63
    s_nop 0
    v_mul_f32 v[vR], s25, v[vC+2]
    v_mul_f32 v[vR+1], s26, v[vC+2]
    v_fma_f32 v[vR+1], -v[vR], v[vR], v[vR+1]
    v_cvt_pk_bf16_f32 v[vR+1], 0, v[vR+1]
    v_add_f32 v[vR+1], s23, v[vR+1]
    v_cvt_pk_bf16_f32 v[vR+1], 0, v[vR+1]
    v_sqrt_f32 v[vR+1], v[vR+1]
    v_sub_f32 v[vR], s24, v[vR]
    v_cvt_pk_bf16_f32 v[vR+1], 0, v[vR+1]
    v_cvt_pk_bf16_f32 v[vR], 0, v[vR]
    v_rcp_f32 v[vR+2], v[vR+1]
    v_sub_f32 v[vR], s24, v[vR]
    v_mul_f32 v[vR+3], v[vR], v[vR+2]
.if \first
    PAD2 1, vB+4, vB+6
    PAD2 1, vB+6, vB+7
.endif
    v_pk_fma_f32 v[\x:\x+1], v[\x:\x+1], v[vR+2:vR+3], v[vR+2:vR+3] op_sel:[0,0,1] op_sel_hi:[1,0,1] neg_lo:[0,1,0] neg_hi:[0,1,0]
    v_pk_fma_f32 v[\x+2:\x+3], v[\x+2:\x+3], v[vR+2:vR+3], v[vR+2:vR+3] op_sel:[0,0,1] op_sel_hi:[1,0,1] neg_lo:[0,1,0] neg_hi:[0,1,0]
    v_pk_fma_f32 v[\x+4:\x+5], v[\x+4:\x+5], v[vR+2:vR+3], v[vR+2:vR+3] op_sel:[0,0,1] op_sel_hi:[1,0,1] neg_lo:[0,1,0] neg_hi:[0,1,0]
    v_pk_fma_f32 v[\x+6:\x+7], v[\x+6:\x+7], v[vR+2:vR+3], v[vR+2:vR+3] op_sel:[0,0,1] op_sel_hi:[1,0,1] neg_lo:[0,1,0] neg_hi:[0,1,0]
    v_pk_fma_f32 v[\x:\x+1], v[\x:\x+1], v[vG:vG+1], v[vB:vB+1]
    v_pk_fma_f32 v[\x+2:\x+3], v[\x+2:\x+3], v[vG+2:vG+3], v[vB+2:vB+3]
    v_pk_fma_f32 v[\x+4:\x+5], v[\x+4:\x+5], v[vG+4:vG+5], v[vB+4:vB+5]
    v_pk_fma_f32 v[\x+6:\x+7], v[\x+6:\x+7], v[vG+6:vG+7], v[vB+6:vB+7]
    v_cvt_pk_bf16_f32 v[\o], v[\x], v[\x+1]
    v_cvt_pk_bf16_f32 v[\o+1], v[\x+2], v[\x+3]
    v_cvt_pk_bf16_f32 v[\o+2], v[\x+4], v[\x+5]
    v_cvt_pk_bf16_f32 v[\o+3], v[\x+6], v[\x+7]
.endm

.macro MAPSTEPS
    s_lshr_b32 s36, s34, 4
    s_add_u32 s36, s36, s2
    s_bfe_u32 s22, s36, 0x10001
    s_lshl_b32 s22, s22, 7
    s_bfe_u32 s3, s36, 0x10000
    s_lshl_b32 s3, s3, 8
    s_or_b32 s22, s22, s3
    s_bfe_u32 s3, s36, 0x10002
    s_lshl_b32 s3, s3, 1
    s_or_b32 s22, s22, s3
    s_or_b32 s22, s22, s37
    s_lshr_b32 s3, s34, 8
    s_xor_b32 s3, s3, s34
    s_and_b32 s3, s3, 2
    s_or_b32 s3, s3, s38
    s_cselect_b32 s3, 16, 0
    s_cselect_b32 s36, s12, s4
    s_lshr_b32 s34, s34, s3
    s_and_b32 s34, s34, 2
    s_xor_b32 s22, s22, s34
    s_xor_b32 s3, s22, 2
    s_lshr_b32 s36, s36, 12
    s_sub_u32 s22, s22, s36
    s_sub_u32 s3, s3, s36
    s_and_b32 s22, s22, 0x1ff
    s_and_b32 s3, s3, 0x1ff
    s_lshl_b32 s22, s22, 12
    s_lshl_b32 s3, s3, 12
    v_add_u32 v[vODD], s3, v[vEVEN]
    v_add_u32 v[vEVEN], s22, v[vEVEN]
    LOADROW vS0, vODD, s43
.endm

.globl standalone__deepnorm__sampling_kernel
.p2align 8
.type standalone__deepnorm__sampling_kernel,@function
standalone__deepnorm__sampling_kernel:
    s_load_dwordx2 s[4:5], s[0:1], 0
    s_load_dwordx2 s[8:9], s[0:1], 8
    v_readfirstlane_b32 s34, v0
    s_sub_u32 s35, s2, 1
    s_load_dwordx2 s[12:13], s[0:1], 40
    s_load_dwordx2 s[32:33], s[0:1], 48
    s_load_dwordx4 s[16:19], s[0:1], 16
    s_load_dwordx2 s[28:29], s[0:1], 32
    s_and_b32 s36, s35, 0xff27
    s_or_b32 s36, s36, s34
    s_cbranch_scc1 L_main
    s_bfe_u32 s34, s35, 0x20003
    s_lshr_b32 s35, s35, 6
    s_lshl2_add_u32 s34, s35, s34
    s_cmpk_ge_u32 s34, 9
    s_mov_b32 s36, 1
    s_cbranch_scc1 L_main
    s_mul_i32 s35, s34, 86
    s_lshr_b32 s35, s35, 8
    s_mul_i32 s3, s35, 3
    s_sub_u32 s26, s34, s3
    s_mul_i32 s25, s35, 0x14900
    s_add_u32 s25, s25, 0x800000
    s_getreg_b32 s21, hwreg(HW_REG_XCC_ID, 0, 3)
    s_sub_u32 s20, s21, s2
    s_and_b32 s20, s20, 7
    s_lshl_b32 s20, s20, 4
    s_cmp_eq_u32 s34, 0
    s_cselect_b32 s20, s20, 0
    s_cmp_eq_u32 s26, 0
    s_waitcnt lgkmcnt(0)
    s_cselect_b64 s[36:37], s[4:5], s[8:9]
    s_cmp_eq_u32 s26, 2
    s_cselect_b64 s[36:37], s[12:13], s[36:37]
    s_add_u32 s36, s36, s25
    s_addc_u32 s37, s37, 0
    s_bitset0_b32 s36, 13
    s_load_dword s48, s[36:37], 0
    s_load_dword s49, s[36:37], 0x2000
    s_waitcnt lgkmcnt(1)
    s_lshr_b32 s21, s21, 2
    s_bitset1_b32 s20, 24
    s_lshl_b32 s34, s26, 3
    s_getreg_b32 s50, hwreg(HW_REG_IB_STS, 8, 4)
    s_cmp_eq_u32 s50, 0
    s_cselect_b32 s50, 1, 0
    s_xor_b32 s50, s50, s21
    s_lshl_b32 s50, s50, s34
    s_or_b32 s50, s50, s20
    s_atomic_add s50, s[32:33], 188
    s_atomic_add s50, s[32:33], 60
    s_atomic_add s50, s[32:33], 124
    s_mov_b32 s36, 0
L_main:
    s_cmpk_ge_u32 s2, 512
    s_cbranch_scc1 L_end
    s_and_b32 s27, s2, 7
    s_lshl_b32 s27, s27, 6
    s_bfe_u32 s3, s2, 0x60003
    s_or_b32 s27, s27, s3
    s_lshl_b32 s27, s27, 12
    v_lshlrev_b32 v[vEVEN], 4, v0
    v_add_u32 v[vOFF], s27, v[vEVEN]
    v_and_b32 v[vLANE], 0x3ff, v[vEVEN]
    s_mov_b32 s6, 0x1000000
    s_mov_b32 s7, 0x20000
    s_mov_b32 s10, 0x1000000
    s_mov_b32 s11, 0x20000
    s_mov_b32 s41, 0x200000
    v_mov_b32 v[vZERO], 0
    s_cmp_eq_u32 s36, 0
    s_cbranch_scc1 L_go
    s_waitcnt lgkmcnt(0)
L_go:
    LOADROW vS0, vOFF, 0
    global_load_dwordx4 v[vG+4:vG+7], v[vLANE], s[16:17]
    global_load_dwordx4 v[vB+4:vB+7], v[vLANE], s[18:19]
    global_load_ushort v[vC+3], v[vZERO], s[28:29]
    LOADROW vS1, vOFF, s41
    s_mov_b32 s14, 0x1000000
    s_mov_b32 s15, 0x20000
    s_mov_b32 s42, 0x400000
    s_mov_b32 s43, 0x600000
    s_mov_b32 s44, 0x800000
    s_mov_b32 s45, 0xa00000
    s_mov_b32 s46, 0xc00000
    s_mov_b32 s47, 0xe00000
    s_mov_b32 s23, 0x3727c5ac
    v_mov_b32 v[vC], 0xbf80
    v_mov_b32 v[vC+1], 0xbf800000
    v_mov_b32 v[vC+2], 0x3b000000
    v_mov_b32 v[vODD], v[vOFF]
    s_bfe_u32 s37, s2, 0x10004
    s_bfe_u32 s3, s2, 0x10003
    s_lshl_b32 s3, s3, 2
    s_or_b32 s37, s37, s3
    s_bfe_u32 s3, s2, 0x40005
    s_lshl_b32 s3, s3, 3
    s_or_b32 s37, s37, s3
    s_xor_b32 s38, s4, s8
    s_and_b32 s38, s38, 0x3fff
    s_waitcnt vmcnt(5)
    LOADROW vS2, vOFF, s42
    s_waitcnt vmcnt(4)
    v_readfirstlane_b32 s20, v[vC+3]
    s_lshl_b32 s21, s20, 16
    ROW vS0, vH0, 1
    s_load_dword s34, s[32:33], 188
    s_waitcnt vmcnt(2)
    s_mov_b32 s35, 0
    s_waitcnt lgkmcnt(0)
    s_cmp_ge_u32 s34, 0x9000000
    s_cbranch_scc0 L_later
    MAPSTEPS
    s_mov_b32 s35, 1
L_later:
    s_load_dword s34, s[32:33], 60
    ROW vS1, vH1, 0
    s_cmp_eq_u32 s35, 0
    s_cbranch_scc1 L_retry
L_mapped:
    s_waitcnt vmcnt(2)
    LOADROW vS1, vEVEN, s44
    STOREROW vH0, vOFF, 0
    ROW vS2, vH2, 0
    s_waitcnt vmcnt(3)
    LOADROW vS2, vODD, s45
    STOREROW vH1, vOFF, s41
    ROW vS0, vP, 0
    STOREROW vP, vODD, s43
    s_waitcnt vmcnt(5)
    LOADROW vS0, vEVEN, s46
    STOREROW vH2, vOFF, s42
    ROW vS1, vP, 0
    STOREROW vP, vEVEN, s44
    s_waitcnt vmcnt(6)
    LOADROW vS1, vODD, s47
    ROW vS2, vP, 0
    STOREROW vP, vODD, s45
    s_waitcnt vmcnt(5)
    ROW vS0, vP, 0
    STOREROW vP, vEVEN, s46
    s_waitcnt vmcnt(2)
    ROW vS1, vP, 0
    STOREROW vP, vODD, s47
L_end:
    s_endpgm

L_retry:
    s_waitcnt lgkmcnt(0)
    s_cmp_ge_u32 s34, 0x9000000
    s_cbranch_scc1 L_have
    s_load_dword s34, s[32:33], 124
    s_movk_i32 s36, 0x7fff
    s_waitcnt lgkmcnt(0)
L_poll:
    s_cmp_ge_u32 s34, 0x9000000
    s_cbranch_scc1 L_have
    s_sub_u32 s36, s36, 1
    s_cbranch_scc1 L_have
    global_load_dword v[vODD], v[vZERO], s[32:33] offset:188 sc1
    s_waitcnt vmcnt(0)
    v_readfirstlane_b32 s34, v[vODD]
    s_branch L_poll
L_have:
    MAPSTEPS
    s_branch L_mapped

.section .rodata,"a"
.p2align 6
.amdhsa_kernel standalone__deepnorm__sampling_kernel
  .amdhsa_next_free_vgpr 78
  .amdhsa_next_free_sgpr 52
  .amdhsa_accum_offset 80
  .amdhsa_group_segment_fixed_size 0
  .amdhsa_kernarg_size 64
  .amdhsa_user_sgpr_count 2
  .amdhsa_user_sgpr_kernarg_segment_ptr 1
  .amdhsa_system_sgpr_workgroup_id_x 1
  .amdhsa_float_denorm_mode_32 3
.end_amdhsa_kernel
```
